```python
import torch

def _softmax(x, axis=-1):
    return torch.softmax(x, dim=axis)
def _gelu(x):
    return torch.nn.functional.gelu(x, approximate="tanh")
def _silu(x):
    return torch.nn.functional.silu(x)
def _sigmoid(x):
    return torch.sigmoid(x)
def _layernorm(x, axis=-1, eps=1e-5):
    m = x.mean(dim=axis, keepdim=True)
    v = x.var(dim=axis, keepdim=True, unbiased=False)
    return (x - m) / torch.sqrt(v + eps)
def _scatter_add(tgt, idx, src, axis=0):
    return tgt.clone().index_add_(axis, idx, src)
def _segment_sum(src, seg, n):
    out = torch.zeros((n,) + src.shape[1:], dtype=src.dtype)
    return out.index_add_(0, seg, src)
def _pad(x, pw):
    flat = tuple(v for pair in reversed(pw) for v in pair)
    return torch.nn.functional.pad(x, flat)

kernel_name = 'recurrent_scan__sliding_block_cached__glu_gated_swiglu__decode'

def setup_inputs():

    _w = (lambda a: (lambda t: t.to(torch.bfloat16) if t.is_floating_point() else t)(torch.as_tensor(a)))
    def _A_setup():
        B, Sq, D = 1, 1, 576
        Hq, Hkv, Sk, Dh = 32, 16, 65536, 128
        assert Hq % Hkv == 0, (Hq, Hkv)
        return {
            "x": _w((lambda *s: torch.randn(*s, dtype=torch.bfloat16) * 0.05)(B, Sq, D)),
            "k_cache": _w((lambda *s: torch.randn(*s, dtype=torch.bfloat16) * 3.2)(B, Hkv, Sk, Dh)),
            "v_cache": _w((lambda *s: torch.randn(*s, dtype=torch.bfloat16) * 3.2)(B, Hkv, Sk, Dh)),
            "wq": _w((lambda *s: torch.randn(*s, dtype=torch.bfloat16) * 3.2)(D, Hq * Dh) * (D ** -0.5)),
            "wo": _w((lambda *s: torch.randn(*s, dtype=torch.bfloat16) * 3.2)(Hq * Dh, D) * ((Hq * Dh) ** -0.5)),
        }
    _A_in = _A_setup()

    def _B_setup():
        B, S, D, F = 1, 1, 576, 4608
        return {
            "x": _w((lambda *s: torch.randn(*s, dtype=torch.bfloat16) * 0.05)(B, S, D)),
            "w1": _w((lambda *s: torch.randn(*s, dtype=torch.bfloat16) * 0.4)(D, F) * (2.0 / D) ** 0.5),
            "w3": _w((lambda *s: torch.randn(*s, dtype=torch.bfloat16) * 0.4)(D, F) * (2.0 / D) ** 0.5),
            "w2": _w((lambda *s: torch.randn(*s, dtype=torch.bfloat16) * 0.4)(F, D) * (2.0 / F) ** 0.5),
        }
    _B_in = _B_setup()

    return {
        "A_x": _A_in["x"],
        "A_k_cache": _A_in["k_cache"],
        "A_v_cache": _A_in["v_cache"],
        "A_wq": _A_in["wq"],
        "A_wo": _A_in["wo"],
        "B_x": _B_in["x"],
        "B_w1": _B_in["w1"],
        "B_w3": _B_in["w3"],
        "B_w2": _B_in["w2"],
    }

def reference(A_x, A_k_cache, A_v_cache, A_wq, A_wo, B_x, B_w1, B_w3, B_w2):
    def _A_ref(x, k_cache, v_cache, wq, wo):
        B, Sq, D = x.shape
        Hq, Dh = 32, 128
        Hkv, Sk = k_cache.shape[1], k_cache.shape[2]
        W = min(4096, max(256, Sk // 4))
        rep = Hq // Hkv
        q = (lambda x, *d: x.permute(*d))((x @ wq).reshape(B, Sq, Hq, Dh), 0, 2, 1, 3)
        k = (lambda x, n, axis: torch.repeat_interleave(x, n, dim=axis))(k_cache[:, :, Sk - W:, :], rep, axis=1)
        v = (lambda x, n, axis: torch.repeat_interleave(x, n, dim=axis))(v_cache[:, :, Sk - W:, :], rep, axis=1)
        scores = torch.einsum("bhqd,bhkd->bhqk", q, k) * (Dh ** -0.5)
        p = _softmax(scores, axis=-1)
        o = torch.einsum("bhqk,bhkd->bhqd", p, v)
        return (lambda x, *d: x.permute(*d))(o, 0, 2, 1, 3).reshape(B, Sq, Hq * Dh) @ wo

    def _B_ref(x, w1, w3, w2):
        gate = torch.einsum("bsd,df->bsf", x, w1)
        up = torch.einsum("bsd,df->bsf", x, w3)
        h = _silu(gate) * up
        out = torch.einsum("bsf,fd->bsd", h, w2)
        return out

    x = A_x
    xn = _layernorm(x, axis=-1)
    s = _A_ref(xn, A_k_cache, A_v_cache, A_wq, A_wo)
    g = _silu(_B_ref(xn, B_w1, B_w3, B_w2))
    return x + s * g
```

```asm
; @launch grid=(256,1,1) block=(1024,1,1) lds=8192
.amdgcn_target "amdgcn-amd-amdhsa--gfx950"
.text
.globl recurrent_scan__sliding_block_cached__glu_gated_swiglu__decode_kernel
.p2align 12
.p2align 8
.type recurrent_scan__sliding_block_cached__glu_gated_swiglu__decode_kernel,@function
recurrent_scan__sliding_block_cached__glu_gated_swiglu__decode_kernel:
  v_lshrrev_b32 v1, 6, v0
  s_cmp_ge_u32 s2, 256
  v_readfirstlane_b32 s3, v1
  s_cbranch_scc1 L_end
  v_mov_b32 v11, 0
  v_and_b32 v0, 63, v0
  s_cmp_eq_u32 s3, 1
  s_cbranch_scc0 L_noinit
  v_lshlrev_b32 v1, 2, v0
  ds_write_b32 v1, v11
  s_waitcnt lgkmcnt(0)
L_noinit:
  s_load_dwordx16 s[4:19], s[0:1], 0
  s_load_dwordx8 s[20:27], s[0:1], 64
  s_barrier
  s_bitcmp1_b32 0xf3, s3
  s_cbranch_scc1 L_tret
  s_mov_b64 exec, 0
  s_cmp_eq_u32 s3, 8
  s_cbranch_scc1 L_touch0
  s_cmp_eq_u32 s3, 9
  s_cbranch_scc1 L_touch1
  s_cmp_eq_u32 s3, 10
  s_cbranch_scc1 L_touch2
  s_cmp_eq_u32 s3, 11
  s_cbranch_scc1 L_touch3
  s_cmp_eq_u32 s3, 12
  s_cbranch_scc1 L_touch4
  s_cmp_eq_u32 s3, 13
  s_cbranch_scc1 L_touch5
  s_cmp_eq_u32 s3, 14
  s_cbranch_scc1 L_touch6
  s_cmp_eq_u32 s3, 15
  s_cbranch_scc1 L_touch7
  s_cmp_eq_u32 s3, 2
  s_cbranch_scc1 L_touch8
L_tret:
  s_mov_b64 exec, -1
  v_mov_b32 v18, 1
  v_mov_b32 v10, 0
  v_mov_b32 v39, 0
  v_mul_u32_u24 v26, 20, v0
  s_and_b32 s49, s2, 7
  s_bfe_u32 s47, s2, 0x40003
  s_lshr_b32 s48, s2, 7
  s_lshl1_add_u32 s46, s49, s48
  s_mov_b32 s35, 0x20000
  s_mov_b32 s31, s35
  s_mov_b32 s39, s35
  s_movk_i32 s38, 1152
  s_mov_b32 s42, -1
  s_cmp_lg_u32 s3, 0
  s_cbranch_scc1 L_notwq
  s_mov_b32 s43, 0
  s_setprio 3
  s_movk_i32 s41, 8192
  s_mov_b32 s48, 147456
  v_and_b32 v17, 15, v0
  v_lshrrev_b32 v16, 4, v0
  v_lshlrev_b32 v17, 4, v17
  v_mad_u32_u24 v1, v16, s48, v17
  s_lshr_b32 s62, s2, 6
  s_and_b32 s50, s47, 1
  s_lshl1_add_u32 s62, s62, s50
  s_bfe_u32 s50, s47, 0x20001
  s_lshl2_add_u32 s45, s49, s50
  s_mul_i32 s40, s62, 589824
  s_lshl_b32 s49, s45, 8
  s_add_u32 s40, s40, s49
  s_mov_b32 s34, 4718592
  v_mov_b32 v21, 32
  s_waitcnt lgkmcnt(0)
  s_mov_b64 s[36:37], s[4:5]
  s_mov_b64 s[32:33], s[10:11]
  buffer_load_dwordx4 v[36:39], v26, s[36:39], 0 offen
  buffer_load_dword v40, v26, s[36:39], 0 offen offset:16
  s_load_dword s44, s[26:27], 0
L_load18:
  buffer_load_dwordx4 v[56:59], v1, s[32:35], s40 offen nt
  s_add_u32 s40, s40, s41
  buffer_load_dwordx4 v[60:63], v1, s[32:35], s40 offen nt
  s_add_u32 s40, s40, s41
L_load16:
  buffer_load_dwordx4 v[64:67], v1, s[32:35], s40 offen nt
  s_add_u32 s40, s40, s41
  s_and_b32 s40, s40, s42
  buffer_load_dwordx4 v[68:71], v1, s[32:35], s40 offen nt
  s_add_u32 s40, s40, s41
  s_and_b32 s40, s40, s42
  buffer_load_dwordx4 v[72:75], v1, s[32:35], s40 offen nt
  s_add_u32 s40, s40, s41
  s_and_b32 s40, s40, s42
  buffer_load_dwordx4 v[76:79], v1, s[32:35], s40 offen nt
  s_add_u32 s40, s40, s41
  s_and_b32 s40, s40, s42
  buffer_load_dwordx4 v[80:83], v1, s[32:35], s40 offen nt
  s_add_u32 s40, s40, s41
  s_and_b32 s40, s40, s42
  buffer_load_dwordx4 v[84:87], v1, s[32:35], s40 offen nt
  s_add_u32 s40, s40, s41
  s_and_b32 s40, s40, s42
  buffer_load_dwordx4 v[88:91], v1, s[32:35], s40 offen nt
  s_add_u32 s40, s40, s41
  s_and_b32 s40, s40, s42
  buffer_load_dwordx4 v[92:95], v1, s[32:35], s40 offen nt
  s_add_u32 s40, s40, s41
  s_and_b32 s40, s40, s42
L_load8:
  buffer_load_dwordx4 v[96:99], v1, s[32:35], s40 offen nt
  s_add_u32 s40, s40, s41
  s_and_b32 s40, s40, s42
  buffer_load_dwordx4 v[100:103], v1, s[32:35], s40 offen nt
  s_add_u32 s40, s40, s41
  s_and_b32 s40, s40, s42
  buffer_load_dwordx4 v[104:107], v1, s[32:35], s40 offen nt
  s_add_u32 s40, s40, s41
  s_and_b32 s40, s40, s42
  buffer_load_dwordx4 v[108:111], v1, s[32:35], s40 offen nt
  s_add_u32 s40, s40, s41
  s_and_b32 s40, s40, s42
  buffer_load_dwordx4 v[112:115], v1, s[32:35], s40 offen nt
  s_add_u32 s40, s40, s41
  s_and_b32 s40, s40, s42
  buffer_load_dwordx4 v[116:119], v1, s[32:35], s40 offen nt
  s_add_u32 s40, s40, s41
  s_and_b32 s40, s40, s42
  buffer_load_dwordx4 v[120:123], v1, s[32:35], s40 offen nt
  ds_add_u32 v21, v18
  s_add_u32 s40, s40, s41
  s_and_b32 s40, s40, s42
  buffer_load_dwordx4 v[124:127], v1, s[32:35], s40 offen nt
  s_branch L_post
L_notwq:
  v_lshrrev_b32 v16, 3, v0
  s_sub_u32 s50, s3, 4
  s_cmp_ge_u32 s50, 8
  s_cbranch_scc1 L_tile
  s_and_b32 s62, s3, 3
  s_lshl_b32 s48, s62, 10
  v_lshl_add_u32 v1, v0, 4, s48
  s_lshr_b32 s40, s2, 3
  s_add_u32 s40, s40, s2
  s_and_b32 s40, s40, 15
  s_lshl_b32 s40, s40, 12
  s_movk_i32 s41, 4096
  s_mov_b32 s42, 0xffff
  s_add_u32 s34, s42, 1
  s_lshl_b32 s48, s46, 8
  s_add_u32 s48, s48, s47
  s_addk_i32 s48, 0xf0
  s_lshl_b32 s48, s48, 16
  s_cmp_lt_u32 s3, 8
  s_cselect_b32 s43, 2, 3
  s_cselect_b32 s49, 36, 44
  s_cselect_b32 s50, 32, 36
  s_cselect_b32 s63, 64, 0x100
  v_mov_b32 v21, s49
  v_mov_b32 v22, s50
  s_setprio 2
  s_waitcnt lgkmcnt(0)
  s_cselect_b64 s[32:33], s[6:7], s[8:9]
  s_add_u32 s32, s32, s48
  s_addc_u32 s33, s33, 0
L_gate:
  ds_read_b32 v23, v22 offset:0
  s_waitcnt lgkmcnt(0)
  v_cmp_ne_u32 vcc, s63, v23
  s_cbranch_vccnz L_gate
L_gate_ok:
  s_branch L_load16
L_post:
  s_setprio 3
  s_mov_b64 s[28:29], s[26:27]
  s_mov_b32 s30, 1048576
  s_mov_b32 s53, 0xffff0000
  s_movk_i32 s55, 0xff00
  s_cmp_eq_u32 s43, 2
  s_cbranch_scc1 L_kwave
  v_and_b32 v20, 1, v0
  v_cmp_eq_u32 vcc, 1, v20
  v_mov_b32 v21, 0x0c0c0100
  v_mov_b32 v22, 0x0c0c0302
  v_alignbit_b32 v23, v21, v21, 16
  v_cndmask_b32 v21, v21, v23, vcc
  v_alignbit_b32 v23, v22, v22, 16
  v_cndmask_b32 v22, v22, v23, vcc
  v_bfe_u32 v20, v0, 1, 2
  v_mov_b32 v23, 0x0c0c0c0c
  v_cmp_eq_u32 vcc, 0, v20
  v_mov_b32 v12, 0
  s_nop 0
  v_cndmask_b32 v2, v23, v21, vcc
  v_cndmask_b32 v6, v23, v22, vcc
  v_cmp_eq_u32 vcc, 1, v20
  v_mov_b32 v13, 0
  s_nop 0
  v_cndmask_b32 v3, v23, v21, vcc
  v_cndmask_b32 v7, v23, v22, vcc
  v_cmp_eq_u32 vcc, 2, v20
  v_mov_b32 v14, 0
  s_nop 0
  v_cndmask_b32 v4, v23, v21, vcc
  v_cndmask_b32 v8, v23, v22, vcc
  v_cmp_eq_u32 vcc, 3, v20
  v_mov_b32 v15, 0
  s_nop 0
  v_cndmask_b32 v5, v23, v21, vcc
  v_cndmask_b32 v9, v23, v22, vcc
  s_cmp_eq_u32 s43, 3
  s_cbranch_scc1 L_vwave
  s_cmp_ge_u32 s43, 4
  s_cbranch_scc1 L_st2
  v_mul_u32_u24 v1, 36, v16
  s_mul_i32 s48, s62, 144
  v_add_u32 v1, s48, v1
  s_cmp_eq_u32 s43, 1
  s_cbranch_scc1 L_xread
  s_bfm_b64 s[64:65], 58, 0
  s_bfm_b64 s[66:67], 57, 0
  s_waitcnt vmcnt(18)
  v_lshlrev_b32 v42, 16, v36
  v_and_b32 v43, s53, v36
  v_lshlrev_b32 v44, 16, v37
  v_and_b32 v45, s53, v37
  v_lshlrev_b32 v46, 16, v38
  v_and_b32 v47, s53, v38
  v_lshlrev_b32 v48, 16, v39
  v_and_b32 v49, s53, v39
  v_lshlrev_b32 v50, 16, v40
  v_and_b32 v51, s53, v40
  v_add_f32 v27, v42, v43
  v_add_f32 v28, v44, v45
  v_add_f32 v27, v27, v46
  v_add_f32 v28, v28, v47
L_touch0:
  s_cbranch_execz L_tret
  v_add_f32 v27, v27, v48
  v_add_f32 v28, v28, v49
  v_add_f32 v27, v27, v50
  v_add_f32 v28, v28, v51
  v_add_f32 v27, v27, v28
  s_nop 1
  v_add_f32_dpp v27, v27, v27 row_ror:8 row_mask:0xf bank_mask:0xf
  s_nop 1
  v_add_f32_dpp v27, v27, v27 row_ror:4 row_mask:0xf bank_mask:0xf
  s_nop 1
  v_add_f32_dpp v27, v27, v27 row_ror:2 row_mask:0xf bank_mask:0xf
  s_nop 1
  v_add_f32_dpp v27, v27, v27 row_ror:1 row_mask:0xf bank_mask:0xf
  v_mov_b32 v28, v27
  s_nop 1
  v_permlane16_swap_b32 v27, v28
  v_add_f32 v27, v27, v28
  v_mov_b32 v28, v27
  s_nop 1
  v_permlane32_swap_b32 v27, v28
  v_add_f32 v27, v27, v28
  v_mul_f32 v27, 0x3ae38e39, v27
  v_cndmask_b32 v28, 0, v27, s[64:65]
  v_cndmask_b32 v29, 0, v27, s[66:67]
  v_sub_f32 v16, v42, v28
  v_sub_f32 v17, v43, v28
  v_sub_f32 v18, v44, v28
  v_sub_f32 v19, v45, v28
  v_sub_f32 v20, v46, v28
  v_sub_f32 v21, v47, v28
  v_sub_f32 v22, v48, v29
  v_sub_f32 v23, v49, v29
  v_sub_f32 v24, v50, v29
  v_sub_f32 v25, v51, v29
  v_mul_f32 v29, v16, v16
  v_mul_f32 v30, v17, v17
  v_fmac_f32 v29, v18, v18
  v_fmac_f32 v30, v19, v19
  v_fmac_f32 v29, v20, v20
  v_fmac_f32 v30, v21, v21
  v_fmac_f32 v29, v22, v22
  v_fmac_f32 v30, v23, v23
  v_fmac_f32 v29, v24, v24
  v_fmac_f32 v30, v25, v25
  v_add_f32 v29, v29, v30
  v_cvt_pk_bf16_f32 v31, v27, v27
  v_and_b32 v31, s53, v31
  v_add_f32_dpp v29, v29, v29 row_ror:8 row_mask:0xf bank_mask:0xf
  v_sub_f32 v16, v42, v31
  v_sub_f32 v17, v43, v31
  v_add_f32_dpp v29, v29, v29 row_ror:4 row_mask:0xf bank_mask:0xf
  v_sub_f32 v18, v44, v31
  v_sub_f32 v19, v45, v31
  v_add_f32_dpp v29, v29, v29 row_ror:2 row_mask:0xf bank_mask:0xf
  v_sub_f32 v20, v46, v31
  v_sub_f32 v21, v47, v31
  v_add_f32_dpp v29, v29, v29 row_ror:1 row_mask:0xf bank_mask:0xf
  v_sub_f32 v22, v48, v31
  v_sub_f32 v23, v49, v31
  v_mov_b32 v30, v29
  v_sub_f32 v24, v50, v31
  v_sub_f32 v25, v51, v31
  v_permlane16_swap_b32 v29, v30
  v_add_f32 v29, v29, v30
  v_mov_b32 v30, v29
  v_cvt_pk_bf16_f32 v36, v16, v17
  v_cvt_pk_bf16_f32 v37, v18, v19
  v_permlane32_swap_b32 v29, v30
  v_add_f32 v29, v29, v30
  v_mul_f32 v29, 0x3ae38e39, v29
  v_cvt_pk_bf16_f32 v29, v29, v29
  v_and_b32 v29, s53, v29
  v_add_f32 v29, 0x3727c5ac, v29
  v_cvt_pk_bf16_f32 v29, v29, v29
  v_and_b32 v29, s53, v29
  v_sqrt_f32 v29, v29
  v_cvt_pk_bf16_f32 v38, v20, v21
  v_cvt_pk_bf16_f32 v39, v22, v23
  v_cvt_pk_bf16_f32 v40, v24, v25
  v_cvt_pk_bf16_f32 v29, v29, v29
  v_and_b32 v29, s53, v29
  v_rcp_f32 v30, v29
  v_lshlrev_b32 v16, 16, v36
  v_and_b32 v17, s53, v36
  v_lshlrev_b32 v18, 16, v37
  v_and_b32 v19, s53, v37
  v_lshlrev_b32 v20, 16, v38
  v_and_b32 v21, s53, v38
  v_lshlrev_b32 v22, 16, v39
  v_and_b32 v23, s53, v39
  v_lshlrev_b32 v24, 16, v40
  v_and_b32 v25, s53, v40
  v_mul_f32 v42, v16, v30
  v_mul_f32 v43, v17, v30
  v_mul_f32 v44, v18, v30
  v_mul_f32 v45, v19, v30
  v_mul_f32 v46, v20, v30
  v_mul_f32 v47, v21, v30
  v_mul_f32 v48, v22, v30
  v_mul_f32 v49, v23, v30
  v_mul_f32 v50, v24, v30
  v_mul_f32 v51, v25, v30
  v_fma_f32 v16, -v42, v29, v16
  v_fma_f32 v17, -v43, v29, v17
  v_fma_f32 v18, -v44, v29, v18
  v_fma_f32 v19, -v45, v29, v19
  v_fma_f32 v20, -v46, v29, v20
  v_fma_f32 v21, -v47, v29, v21
  v_fma_f32 v22, -v48, v29, v22
  v_fma_f32 v23, -v49, v29, v23
  v_fma_f32 v24, -v50, v29, v24
  v_fma_f32 v25, -v51, v29, v25
  v_fmac_f32 v42, v16, v30
  v_fmac_f32 v43, v17, v30
  v_fmac_f32 v44, v18, v30
  v_fmac_f32 v45, v19, v30
  v_fmac_f32 v46, v20, v30
  v_fmac_f32 v47, v21, v30
  v_fmac_f32 v48, v22, v30
  v_fmac_f32 v49, v23, v30
  v_fmac_f32 v50, v24, v30
  v_fmac_f32 v51, v25, v30
  v_cvt_pk_bf16_f32 v36, v42, v43
  v_cvt_pk_bf16_f32 v37, v44, v45
  v_cvt_pk_bf16_f32 v38, v46, v47
  v_cvt_pk_bf16_f32 v39, v48, v49
  v_cvt_pk_bf16_f32 v40, v50, v51
  v_mov_b32 v32, 1
  s_waitcnt lgkmcnt(0)
  s_add_u32 s44, s44, 1
  ds_write2_b32 v26, v36, v37 offset0:32 offset1:33
  v_mov_b32 v33, s44
  ds_write2_b32 v26, v38, v39 offset0:34 offset1:35
  ds_write_b32 v26, v40 offset:144
  ds_write_b64 v11, v[32:33] offset:0
  v_and_b32 v24, 0xff, v33
L_xread:
  ds_read_b32 v27, v1 offset:128
  ds_read2_b32 v[28:29], v1 offset0:33 offset1:34
  ds_read2_b32 v[30:31], v1 offset0:35 offset1:36
  ds_read2_b32 v[32:33], v1 offset0:37 offset1:38
  ds_read2_b32 v[34:35], v1 offset0:39 offset1:40
  s_cmp_lg_u32 s3, 1
  s_waitcnt lgkmcnt(0)
  v_perm_b32 v16, v27, v27, v2
  v_perm_b32 v17, v27, v27, v3
  v_perm_b32 v18, v27, v27, v4
  v_perm_b32 v19, v27, v27, v5
  v_perm_b32 v20, v27, v27, v6
  v_perm_b32 v21, v27, v27, v7
  v_perm_b32 v22, v27, v27, v8
  v_perm_b32 v23, v27, v27, v9
  s_waitcnt vmcnt(16)
  v_mfma_f32_16x16x32_bf16 v[12:15], v[16:19], v[56:59], v[12:15]
  s_cbranch_scc1 L_nc
  ds_write_b32 v11, v2 offset:52
L_nc:
  v_mfma_f32_16x16x32_bf16 v[12:15], v[20:23], v[60:63], v[12:15]
L_gemv16:
  v_perm_b32 v16, v28, v28, v2
  v_perm_b32 v17, v28, v28, v3
  v_perm_b32 v18, v28, v28, v4
  v_perm_b32 v19, v28, v28, v5
  v_perm_b32 v20, v28, v28, v6
  v_perm_b32 v21, v28, v28, v7
  v_perm_b32 v22, v28, v28, v8
  v_perm_b32 v23, v28, v28, v9
  s_waitcnt vmcnt(14)
  v_mfma_f32_16x16x32_bf16 v[12:15], v[16:19], v[64:67], v[12:15]
  v_perm_b32 v16, v29, v29, v2
  v_perm_b32 v17, v29, v29, v3
  v_perm_b32 v18, v29, v29, v4
  v_perm_b32 v19, v29, v29, v5
  v_mfma_f32_16x16x32_bf16 v[12:15], v[20:23], v[68:71], v[12:15]
  v_perm_b32 v20, v29, v29, v6
  v_perm_b32 v21, v29, v29, v7
  v_perm_b32 v22, v29, v29, v8
  v_perm_b32 v23, v29, v29, v9
  s_waitcnt vmcnt(12)
  v_mfma_f32_16x16x32_bf16 v[12:15], v[16:19], v[72:75], v[12:15]
  v_perm_b32 v16, v30, v30, v2
  v_perm_b32 v17, v30, v30, v3
  v_perm_b32 v18, v30, v30, v4
  v_perm_b32 v19, v30, v30, v5
  v_mfma_f32_16x16x32_bf16 v[12:15], v[20:23], v[76:79], v[12:15]
  v_perm_b32 v20, v30, v30, v6
  v_perm_b32 v21, v30, v30, v7
  v_perm_b32 v22, v30, v30, v8
  v_perm_b32 v23, v30, v30, v9
L_touch1:
  s_cbranch_execz L_tret
  s_waitcnt vmcnt(10)
  v_mfma_f32_16x16x32_bf16 v[12:15], v[16:19], v[80:83], v[12:15]
  v_perm_b32 v16, v31, v31, v2
  v_perm_b32 v17, v31, v31, v3
  v_perm_b32 v18, v31, v31, v4
  v_perm_b32 v19, v31, v31, v5
  v_mfma_f32_16x16x32_bf16 v[12:15], v[20:23], v[84:87], v[12:15]
  v_perm_b32 v20, v31, v31, v6
  v_perm_b32 v21, v31, v31, v7
  v_perm_b32 v22, v31, v31, v8
  v_perm_b32 v23, v31, v31, v9
  s_waitcnt vmcnt(8)
  v_mfma_f32_16x16x32_bf16 v[12:15], v[16:19], v[88:91], v[12:15]
  s_nop 0
  v_mfma_f32_16x16x32_bf16 v[12:15], v[20:23], v[92:95], v[12:15]
L_gemv8:
  v_perm_b32 v16, v32, v32, v2
  v_perm_b32 v17, v32, v32, v3
  v_perm_b32 v18, v32, v32, v4
  v_perm_b32 v19, v32, v32, v5
  v_perm_b32 v20, v32, v32, v6
  v_perm_b32 v21, v32, v32, v7
  v_perm_b32 v22, v32, v32, v8
  v_perm_b32 v23, v32, v32, v9
  s_waitcnt vmcnt(6)
  v_mfma_f32_16x16x32_bf16 v[12:15], v[16:19], v[96:99], v[12:15]
  v_perm_b32 v16, v33, v33, v2
  v_perm_b32 v17, v33, v33, v3
  v_perm_b32 v18, v33, v33, v4
  v_perm_b32 v19, v33, v33, v5
  v_mfma_f32_16x16x32_bf16 v[12:15], v[20:23], v[100:103], v[12:15]
  v_perm_b32 v20, v33, v33, v6
  v_perm_b32 v21, v33, v33, v7
  v_perm_b32 v22, v33, v33, v8
  v_perm_b32 v23, v33, v33, v9
  s_waitcnt vmcnt(4)
  v_mfma_f32_16x16x32_bf16 v[12:15], v[16:19], v[104:107], v[12:15]
  v_perm_b32 v16, v34, v34, v2
  v_perm_b32 v17, v34, v34, v3
  v_perm_b32 v18, v34, v34, v4
  v_perm_b32 v19, v34, v34, v5
  v_mfma_f32_16x16x32_bf16 v[12:15], v[20:23], v[108:111], v[12:15]
  v_perm_b32 v20, v34, v34, v6
  v_perm_b32 v21, v34, v34, v7
  v_perm_b32 v22, v34, v34, v8
  v_perm_b32 v23, v34, v34, v9
  s_waitcnt vmcnt(3)
  v_mfma_f32_16x16x32_bf16 v[12:15], v[16:19], v[112:115], v[12:15]
  v_perm_b32 v16, v35, v35, v2
  v_perm_b32 v17, v35, v35, v3
  v_perm_b32 v18, v35, v35, v4
  v_perm_b32 v19, v35, v35, v5
  s_waitcnt vmcnt(2)
  v_mfma_f32_16x16x32_bf16 v[12:15], v[20:23], v[116:119], v[12:15]
  v_perm_b32 v20, v35, v35, v6
  v_perm_b32 v21, v35, v35, v7
  v_perm_b32 v22, v35, v35, v8
  v_perm_b32 v23, v35, v35, v9
  s_waitcnt vmcnt(1)
  v_mfma_f32_16x16x32_bf16 v[12:15], v[16:19], v[120:123], v[12:15]
  s_nop 0
  s_waitcnt vmcnt(0)
  v_mfma_f32_16x16x32_bf16 v[12:15], v[20:23], v[124:127], v[12:15]
  s_cmp_eq_u32 s43, 3
  s_nop 2
  s_cbranch_scc1 L_vpost
  s_cmp_eq_u32 s43, 0
  s_cbranch_scc1 L_qpost
  s_cmp_eq_u32 s43, 1
  v_permlane32_swap_b32 v12, v16
  v_permlane32_swap_b32 v13, v17
  v_permlane32_swap_b32 v14, v18
  v_permlane32_swap_b32 v15, v19
  v_add_f32_dpp v12, v16, v12 row_ror:8 row_mask:0xf bank_mask:0xf
  v_add_f32_dpp v13, v17, v13 row_ror:8 row_mask:0xf bank_mask:0xf
  v_add_f32_dpp v14, v18, v14 row_ror:8 row_mask:0xf bank_mask:0xf
  v_add_f32_dpp v15, v19, v15 row_ror:8 row_mask:0xf bank_mask:0xf
  s_mov_b64 exec, 0x00ff00ff
  v_and_or_b32 v12, v12, s55, v24
  s_cbranch_scc1 L_tp1
  s_cmp_eq_u32 s76, 1
  s_cbranch_scc0 L_tp0
  buffer_store_dwordx4 v[12:15], v26, s[28:31], s45 offen
  s_branch L_fin
L_tp0:
  buffer_store_dwordx4 v[12:15], v26, s[28:31], s45 offen sc1
  s_branch L_fin
L_tp1:
  buffer_store_dwordx4 v[12:15], v26, s[28:31], s45 offen sc1
  v_mov_b32 v10, 4
  ds_add_u32 v11, v10 offset:40
L_fin:
  s_mov_b64 exec, 1
  v_mov_b32 v16, 1
  ds_add_u32 v11, v16 offset:24
  s_branch L_exit
L_qpost:
  v_and_b32 v20, 15, v0
  v_and_or_b32 v12, v12, s55, v24
  v_and_b32 v21, 16, v0
  v_lshl_add_u32 v20, v20, 5, v21
  s_lshr_b32 s49, s45, 1
  s_lshl3_add_u32 s49, s49, s62
  s_and_b32 s48, s45, 1
  s_lshl1_add_u32 s49, s49, s48
  s_lshl_b32 s49, s49, 9
  s_add_u32 s49, s49, 4096
  s_mov_b32 exec_hi, 0
  buffer_store_dwordx4 v[12:15], v20, s[28:31], s49 offen sc1
  s_mov_b32 exec_hi, -1
  s_and_b32 s48, s2, 7
  s_lshr_b32 s49, s2, 6
  s_lshl2_add_u32 s54, s48, s49
  s_and_b32 s50, s47, 7
  s_cmp_eq_u32 s50, 3
  s_cselect_b32 s54, s54, -1
  s_and_b32 s50, s2, 63
  s_add_u32 s49, s49, 32
  s_cmp_eq_u32 s50, 23
  s_cselect_b32 s54, s49, s54
  s_getreg_b32 s73, hwreg(HW_REG_XCC_ID, 0, 4)
  s_lshl4_add_u32 s73, s44, s73
  s_cmp_lt_u32 s54, 36
  s_cbranch_scc0 L_nored
  s_and_b32 s49, s54, 3
  s_andn2_b32 s50, s54, 3
  s_lshl3_add_u32 s49, s50, s49
  s_lshl_b32 s49, s49, 2
  v_mov_b32 v21, s73
  s_mov_b64 exec, 1
  buffer_store_dword v21, v11, s[28:31], s49 offen offset:256 sc1
  s_mov_b64 exec, -1
L_nored:
  s_lshl_b32 s48, s46, 13
  s_add_u32 s48, s48, 4096
  v_lshlrev_b32 v1, 4, v0
  s_add_u32 s49, s48, 4096
  s_mov_b32 s52, 200000
  s_waitcnt vmcnt(0)
L_qpoll:
  buffer_load_dwordx4 v[64:67], v1, s[28:31], s48 offen offset:0 sc1
  buffer_load_dwordx4 v[68:71], v1, s[28:31], s48 offen offset:1024 sc1
  buffer_load_dwordx4 v[72:75], v1, s[28:31], s48 offen offset:2048 sc1
  buffer_load_dwordx4 v[76:79], v1, s[28:31], s48 offen offset:3072 sc1
  buffer_load_dwordx4 v[80:83], v1, s[28:31], s49 offen offset:0 sc1
  buffer_load_dwordx4 v[84:87], v1, s[28:31], s49 offen offset:1024 sc1
  buffer_load_dwordx4 v[88:91], v1, s[28:31], s49 offen offset:2048 sc1
  buffer_load_dwordx4 v[92:95], v1, s[28:31], s49 offen offset:3072 sc1
  s_sub_u32 s52, s52, 1
  s_waitcnt vmcnt(0)
  s_cbranch_scc1 L_qgo
  v_xor_b32 v64, v24, v64
  v_xor_b32 v68, v24, v68
  v_xor_b32 v72, v24, v72
  v_xor_b32 v76, v24, v76
  v_xor_b32 v80, v24, v80
  v_xor_b32 v84, v24, v84
  v_xor_b32 v88, v24, v88
  v_xor_b32 v92, v24, v92
  v_or3_b32 v36, v64, v68, v72
  v_or3_b32 v36, v36, v76, v80
  v_or3_b32 v36, v36, v84, v88
  v_bitop3_b32 v36, v36, v92, s55 bitop3:0x54
  v_cmp_ne_u32 vcc, 0, v36
  s_cbranch_vccnz L_qpoll
L_qgo:
  v_pk_add_f32 v[64:65], v[64:65], v[80:81]
  v_pk_add_f32 v[66:67], v[66:67], v[82:83]
  v_pk_add_f32 v[68:69], v[68:69], v[84:85]
  v_pk_add_f32 v[70:71], v[70:71], v[86:87]
  v_pk_add_f32 v[72:73], v[72:73], v[88:89]
  v_pk_add_f32 v[74:75], v[74:75], v[90:91]
  v_pk_add_f32 v[76:77], v[76:77], v[92:93]
  v_pk_add_f32 v[78:79], v[78:79], v[94:95]
  v_pk_add_f32 v[64:65], v[64:65], v[72:73]
  v_pk_add_f32 v[66:67], v[66:67], v[74:75]
  v_pk_add_f32 v[68:69], v[68:69], v[76:77]
  v_pk_add_f32 v[70:71], v[70:71], v[78:79]
  v_pk_add_f32 v[64:65], v[64:65], v[68:69]
  v_pk_add_f32 v[66:67], v[66:67], v[70:71]
  v_cvt_pk_bf16_f32 v64, v64, v65
L_touch2:
  s_cbranch_execz L_tret
  v_cvt_pk_bf16_f32 v65, v66, v67
  v_lshlrev_b32 v37, 3, v0
  v_mov_b32 v16, 1
  ds_write_b64 v37, v[64:65] offset:1536
  ds_write_b32 v11, v16 offset:8
  s_and_b32 s48, s2, 15
  s_and_b32 s49, s2, 7
  s_cmp_eq_u32 s48, 15
  s_addc_u32 s49, s49, 0
  s_lshl_b32 s49, s49, 7
  s_addk_i32 s49, 256
L_touch3:
  s_cbranch_execz L_tret
  s_load_dwordx4 s[76:79], s[26:27], s49
  s_waitcnt lgkmcnt(0)
  s_xor_b32 s76, s76, s73
  s_xor_b32 s77, s77, s73
  s_xor_b32 s78, s78, s73
  s_xor_b32 s79, s79, s73
  s_or_b64 s[76:77], s[76:77], s[78:79]
  s_cselect_b32 s48, 2, 1
  v_mov_b32 v16, s48
  ds_write_b32 v11, v16 offset:12
  s_cmp_lt_u32 s54, 36
  s_cbranch_scc0 L_exit
  v_and_b32 v37, 3, v0
  v_lshrrev_b32 v40, 4, v0
  v_lshl_add_u32 v39, v37, 3, v40
  s_lshr_b32 s51, s54, 2
  s_and_b32 s50, s54, 1
  s_lshl1_add_u32 s51, s51, s50
  s_lshl_b32 s51, s51, 6
  s_and_b32 s50, s54, 2
  s_lshl2_add_u32 s51, s50, s51
  v_lshl_add_u32 v25, v39, 1, s51
  s_mov_b64 s[36:37], s[4:5]
  s_mov_b64 s[56:57], s[22:23]
  s_mov_b64 s[58:59], s[38:39]
  s_mov_b32 s60, 0x3fb8aa3b
  buffer_load_ushort v10, v25, s[36:39], 0 offen
  buffer_load_ushort v63, v25, s[56:59], 0 offen
  s_mul_i32 s48, s54, 9216
  s_add_u32 s48, s48, 405504
  s_add_u32 s49, s48, 4096
  s_add_u32 s50, s48, 8192
  v_and_b32 v38, 60, v0
  v_lshl_add_u32 v41, v38, 4, v1
  v_mov_b32 v88, 0
  v_mov_b32 v89, 0
  v_mov_b32 v90, 0
  v_mov_b32 v91, 0
  v_mov_b32 v40, 0
  s_mov_b32 exec_hi, 0
  v_mov_b32 v40, v24
  s_mov_b32 exec_hi, -1
  s_waitcnt vmcnt(0)
  v_lshlrev_b32 v10, 16, v10
  s_mov_b32 s52, 200000
L_fwait:
  ds_read_b32 v38, v11 offset:24
  s_waitcnt lgkmcnt(0)
  v_cmp_ne_u32 vcc, 7, v38
  s_cbranch_vccnz L_fwait
L_fwait_ok:
L_fpoll:
  buffer_load_dwordx4 v[64:67], v41, s[28:31], s48 offen offset:0 sc1
  buffer_load_dwordx4 v[68:71], v41, s[28:31], s48 offen offset:2048 sc1
  buffer_load_dwordx4 v[72:75], v1, s[28:31], s49 offen offset:0 sc1
  buffer_load_dwordx4 v[76:79], v1, s[28:31], s49 offen offset:1024 sc1
  buffer_load_dwordx4 v[80:83], v1, s[28:31], s49 offen offset:2048 sc1
  buffer_load_dwordx4 v[84:87], v1, s[28:31], s49 offen offset:3072 sc1
  s_mov_b32 exec_hi, 0
  buffer_load_dwordx4 v[88:91], v41, s[28:31], s50 offen offset:0 sc1
  s_mov_b32 exec_hi, -1
  s_sub_u32 s52, s52, 1
  s_cbranch_scc1 L_exit
  s_waitcnt vmcnt(0)
  v_xor_b32 v64, v24, v64
  v_xor_b32 v68, v24, v68
  v_xor_b32 v72, v24, v72
  v_xor_b32 v76, v24, v76
  v_xor_b32 v80, v24, v80
  v_xor_b32 v84, v24, v84
  v_xor_b32 v88, v40, v88
  v_or3_b32 v38, v64, v68, v72
  v_or3_b32 v38, v38, v76, v80
  v_or3_b32 v38, v38, v84, v88
  v_and_b32 v38, 0xff, v38
  v_cmp_ne_u32 vcc, 0, v38
  s_cbranch_vccnz L_fpoll
  v_pk_add_f32 v[100:101], v[72:73], v[76:77]
  v_pk_add_f32 v[104:105], v[80:81], v[84:85]
  v_pk_add_f32 v[102:103], v[74:75], v[78:79]
  v_pk_add_f32 v[106:107], v[82:83], v[86:87]
  v_pk_add_f32 v[100:101], v[100:101], v[88:89]
  v_pk_add_f32 v[102:103], v[102:103], v[90:91]
  v_pk_add_f32 v[96:97], v[64:65], v[68:69]
  v_pk_add_f32 v[100:101], v[100:101], v[104:105]
  v_pk_add_f32 v[98:99], v[66:67], v[70:71]
  v_pk_add_f32 v[102:103], v[102:103], v[106:107]
  v_permlane32_swap_b32 v96, v100
  v_permlane32_swap_b32 v97, v101
  v_permlane32_swap_b32 v98, v102
  v_permlane32_swap_b32 v99, v103
  v_pk_add_f32 v[96:97], v[96:97], v[100:101]
  v_pk_add_f32 v[98:99], v[98:99], v[102:103]
  s_nop 0
  v_permlane16_swap_b32 v96, v97
  v_permlane16_swap_b32 v98, v99
  v_add_f32 v96, v96, v97
  v_add_f32 v98, v98, v99
  s_nop 0
  v_add_f32_dpp v96, v96, v96 row_ror:4 row_mask:0xf bank_mask:0xf
  v_add_f32_dpp v98, v98, v98 row_ror:4 row_mask:0xf bank_mask:0xf
  s_nop 0
  v_add_f32_dpp v96, v96, v96 row_ror:8 row_mask:0xf bank_mask:0xf
  v_add_f32_dpp v98, v98, v98 row_ror:8 row_mask:0xf bank_mask:0xf
  s_nop 1
  v_permlane32_swap_b32 v96, v98
  v_cvt_pk_bf16_f32 v97, v96, v98
  v_and_b32 v98, s53, v97
  v_mul_f32 v99, s60, v98
  v_exp_f32 v99, -v99
  v_lshlrev_b32 v96, 16, v97
  v_add_f32 v99, 1.0, v99
  v_rcp_f32 v99, v99
  s_mov_b32 exec_lo, 0x000f000f
  v_mul_f32 v99, v98, v99
  v_cvt_pk_bf16_f32 v99, v99, v99
  v_and_b32 v99, s53, v99
  v_mul_f32 v99, v96, v99
  v_cvt_pk_bf16_f32 v99, v99, v99
  v_and_b32 v99, s53, v99
  v_add_f32 v99, v10, v99
  s_mov_b32 exec_hi, exec_lo
  v_cvt_pk_bf16_f32 v99, v99, v99
  buffer_store_short v99, v25, s[56:59], 0 offen
  s_cmp_lg_u32 s54, 0
  s_cbranch_scc1 L_exit
  s_mov_b64 exec, 1
  v_mov_b32 v100, s44
  buffer_store_dword v100, v11, s[28:31], 0 offen
  s_branch L_exit
L_tile:
  v_and_b32 v17, 7, v0
  v_lshlrev_b32 v17, 4, v17
  s_mov_b32 s52, 200000
  v_mov_b32 v21, 44
L_tagw:
  ds_read_b64 v[22:23], v11 offset:0
  s_waitcnt lgkmcnt(0)
  v_cmp_ne_u32 vcc, 1, v22
  s_cbranch_vccnz L_tagw
L_tagw_ok:
  v_readfirstlane_b32 s44, v23
  v_and_b32 v24, 0xff, v23
  s_lshr_b32 s61, s2, 3
  s_movk_i32 s63, 256
  s_cmp_eq_u32 s3, 1
  s_cbranch_scc0 L_rw1
  s_movk_i32 s64, 127
  s_mov_b32 s65, -1
  s_movk_i32 s66, 0
  s_bitcmp1_b32 s64, s49
  s_cbranch_scc1 L_got
  s_movk_i32 s64, 128
  s_mov_b32 s65, 0xc0c0c0c0
  s_movk_i32 s66, 376
  s_bitcmp1_b32 s64, s49
  s_cbranch_scc0 L_ru2
  s_bitcmp1_b32 s65, s61
  s_cbranch_scc1 L_got
L_ru2:
  s_movk_i32 s64, 128
  s_mov_b32 s65, 0x33333333
  s_movk_i32 s66, 12480
  s_bitcmp1_b32 s64, s49
  s_cbranch_scc0 L_ru3
  s_bitcmp1_b32 s65, s61
  s_cbranch_scc1 L_got
L_ru3:
L_rw1:
  s_cmp_eq_u32 s3, 2
  s_cbranch_scc0 L_rw2
  s_movk_i32 s64, 127
  s_mov_b32 s65, 0x3b3b3b3b
  s_movk_i32 s66, 224
  s_bitcmp1_b32 s64, s49
  s_cbranch_scc0 L_ru4
  s_bitcmp1_b32 s65, s61
  s_cbranch_scc1 L_got
L_ru4:
  s_movk_i32 s64, 112
  s_mov_b32 s65, 0x40404040
  s_movk_i32 s66, 364
  s_bitcmp1_b32 s64, s49
  s_cbranch_scc0 L_ru5
  s_bitcmp1_b32 s65, s61
  s_cbranch_scc1 L_got
L_ru5:
  s_movk_i32 s64, 127
  s_mov_b32 s65, 0x84848484
  s_movk_i32 s66, 4096
  s_bitcmp1_b32 s64, s49
  s_cbranch_scc0 L_ru6
  s_bitcmp1_b32 s65, s61
  s_cbranch_scc1 L_got
L_ru6:
  s_movk_i32 s64, 15
  s_mov_b32 s65, 0x40404040
  s_movk_i32 s66, 4152
  s_bitcmp1_b32 s64, s49
  s_cbranch_scc0 L_ru7
  s_bitcmp1_b32 s65, s61
  s_cbranch_scc1 L_got
L_ru7:
  s_movk_i32 s64, 128
  s_mov_b32 s65, -1
  s_movk_i32 s66, 12416
  s_bitcmp1_b32 s64, s49
  s_cbranch_scc1 L_got
L_rw2:
  s_cmp_eq_u32 s3, 3
  s_cbranch_scc0 L_rw3
  s_movk_i32 s64, 127
  s_mov_b32 s65, -1
  s_movk_i32 s66, 20480
  s_bitcmp1_b32 s64, s49
  s_cbranch_scc1 L_claim
  s_movk_i32 s64, 128
  s_mov_b32 s65, -1
  s_movk_i32 s66, 12448
  s_bitcmp1_b32 s64, s49
  s_cbranch_scc1 L_got
L_rw3:
  s_cmp_eq_u32 s3, 12
  s_cbranch_scc0 L_rw12
  s_movk_i32 s64, 127
  s_mov_b32 s65, -1
  s_movk_i32 s66, 8192
  s_bitcmp1_b32 s64, s49
L_touch4:
  s_cbranch_execz L_tret
  s_cbranch_scc1 L_got
  s_movk_i32 s64, 128
  s_mov_b32 s65, -1
  s_movk_i32 s66, 12288
  s_bitcmp1_b32 s64, s49
  s_cbranch_scc1 L_got
L_rw12:
  s_cmp_eq_u32 s3, 13
  s_cbranch_scc0 L_rw13
  s_movk_i32 s64, 127
  s_mov_b32 s65, -1
  s_movk_i32 s66, 8224
  s_bitcmp1_b32 s64, s49
  s_cbranch_scc1 L_got
  s_movk_i32 s64, 128
  s_mov_b32 s65, -1
  s_movk_i32 s66, 12320
  s_bitcmp1_b32 s64, s49
  s_cbranch_scc1 L_got
L_rw13:
  s_cmp_eq_u32 s3, 14
  s_cbranch_scc0 L_rw14
  s_movk_i32 s64, 127
  s_mov_b32 s65, -1
  s_movk_i32 s66, 8256
  s_bitcmp1_b32 s64, s49
  s_cbranch_scc1 L_got
  s_movk_i32 s64, 128
  s_mov_b32 s65, -1
  s_movk_i32 s66, 12352
  s_bitcmp1_b32 s64, s49
  s_cbranch_scc1 L_got
L_rw14:
  s_cmp_eq_u32 s3, 15
  s_cbranch_scc0 L_rw15
  s_movk_i32 s64, 127
  s_mov_b32 s65, 0x88888888
  s_movk_i32 s66, 8288
  s_bitcmp1_b32 s64, s49
  s_cbranch_scc0 L_ru17
  s_bitcmp1_b32 s65, s61
  s_cbranch_scc1 L_got
L_ru17:
  s_movk_i32 s64, 128
  s_mov_b32 s65, -1
  s_movk_i32 s66, 12384
  s_bitcmp1_b32 s64, s49
  s_cbranch_scc1 L_got
L_rw15:
  s_movk_i32 s66, 0x4000
L_got:
  s_bfm_b32 s48, s61, 0
  s_and_b32 s48, s48, s65
  s_bcnt1_i32_b32 s48, s48
  s_and_b32 s50, s66, 0xfff
  s_add_u32 s48, s48, s50
  s_cmp_ge_u32 s66, 0x2000
  s_cbranch_scc1 L_t2
  s_bfm_b32 s50, s49, 0
  s_and_b32 s50, s50, s64
  s_bcnt1_i32_b32 s50, s50
  s_bcnt1_i32_b32 s51, s65
  s_mul_i32 s50, s50, s51
  s_add_u32 s48, s48, s50
L_id:
  s_add_u32 s50, s48, 4
  s_mul_i32 s50, s50, 1171
  s_lshr_b32 s50, s50, 13
  s_add_u32 s50, s50, s48
  s_lshl3_add_u32 s48, s48, 3
  s_cmp_lt_u32 s66, 0x1000
  s_cselect_b32 s48, s50, s48
  s_mov_b32 s43, 1
  s_movk_i32 s41, 9216
  s_mov_b32 s49, 165888
  v_mad_u32_u24 v1, v16, s49, v17
  s_mul_i32 s49, s48, 911
  s_lshr_b32 s49, s49, 16
  s_mul_i32 s50, s49, 72
  s_sub_u32 s50, s48, s50
  s_and_b32 s62, s49, 3
  s_mul_i32 s40, s62, 1327104
  s_lshl_b32 s62, s62, 1
  s_lshl_b32 s51, s50, 7
  s_add_u32 s40, s40, s51
  s_lshl_b32 s45, s48, 8
  s_add_u32 s45, s45, 737280
  v_and_b32 v22, 16, v0
  v_lshl_add_u32 v26, v17, 1, v22
  s_mov_b32 s34, 5308416
  s_cmp_ge_u32 s48, 288
  s_cselect_b64 s[32:33], s[18:19], s[16:17]
L_lgate1:
  ds_read_b32 v22, v11 offset:44
  s_waitcnt lgkmcnt(0)
  v_cmp_gt_u32 vcc, s63, v22
  s_cbranch_vccnz L_lgate1
L_lgate1_ok:
  s_branch L_load18
L_claim:
  s_lshr_b32 s51, s61, 2
  s_lshl_b32 s50, s51, 8
  s_addk_i32 s50, 2048
  s_load_dwordx2 s[64:65], s[26:27], s50 glc
  s_mul_i32 s51, s51, 15
  s_addk_i32 s51, 384
  s_mov_b32 s66, 0
  s_mov_b32 s48, 1
  s_waitcnt lgkmcnt(0)
  s_cmp_eq_u32 s65, s44
  s_cbranch_scc1 L_cg
  v_mov_b32 v36, 0
  v_mov_b32 v37, s44
  v_mov_b32 v38, s64
  v_mov_b32 v39, s65
  v_mov_b32 v40, s50
  s_mov_b64 exec, 1
  global_atomic_cmpswap_x2 v[36:37], v40, v[36:39], s[26:27] sc0 sc1
  s_mov_b64 exec, -1
  s_waitcnt vmcnt(0)
L_cg:
  ds_read_b32 v22, v11 offset:52
  s_waitcnt lgkmcnt(0)
  v_cmp_eq_u32 vcc, 0, v22
  s_cbranch_vccnz L_cg
L_cg_ok:
  s_atomic_add s48, s[26:27], s50 glc
  s_waitcnt lgkmcnt(0)
  s_cmp_lt_u32 s48, 15
  s_cbranch_scc0 L_lost
  s_add_u32 s48, s48, s51
  s_branch L_id
L_lost:
  s_movk_i32 s66, 0x4000
  s_branch L_nox_ok
L_t2:
  s_cmp_ge_u32 s3, 4
  s_cbranch_scc1 L_t2a
L_nox:
  ds_read_b32 v22, v11 offset:44
  s_waitcnt lgkmcnt(0)
  v_cmp_gt_u32 vcc, s63, v22
  s_cbranch_vccnz L_nox
L_nox_ok:
  ds_add_u32 v21, v18
  ds_add_u32 v11, v18 offset:40
L_t2a:
  s_cmp_ge_u32 s66, 0x4000
  s_cbranch_scc1 L_fin
  s_movk_i32 s63, 448
  s_and_b32 s50, s48, 1
  s_add_u32 s50, s50, 7
  s_lshr_b32 s51, s48, 1
  s_cmp_ge_u32 s66, 0x3000
  s_cselect_b32 s50, s50, s49
  s_cselect_b32 s49, s51, s48
  s_cselect_b32 s72, 0, 1
  s_lshl_b32 s48, s49, 1
  s_cmp_ge_u32 s49, 64
  s_cselect_b32 s51, 63, 0
  s_cmp_ge_u32 s49, 96
  s_cselect_b32 s51, 64, s51
  s_sub_u32 s48, s48, s51
  s_mul_i32 s51, s50, 576
  s_add_u32 s48, s48, s51
  s_lshl_b32 s45, s48, 6
  s_add_u32 s45, s45, 405504
  v_bfe_u32 v26, v0, 4, 1
  v_bfe_u32 v22, v0, 2, 1
  v_lshl_add_u32 v22, v26, 1, v22
  v_mul_u32_u24 v22, 9216, v22
  v_and_b32 v26, 3, v0
  v_lshl_add_u32 v26, v26, 4, v22
  v_mov_b32 v21, 28
  s_cmp_ge_u32 s49, 32
  s_cselect_b64 s[32:33], s[20:21], s[12:13]
  s_cselect_b32 s34, 5308416, 0
  s_cselect_b32 s43, 5, 4
  s_cselect_b32 s61, 32, 0
  s_cselect_b32 s51, 9, 18
  s_cselect_b32 s48, 1, 2
  s_cselect_b32 s41, 18, 9
  s_lshl_b32 s41, s41, 8
  s_lshl_b32 s51, s51, 10
  s_max_u32 s34, s34, 4718592
  s_sub_u32 s61, s49, s61
  v_bfe_u32 v22, v16, 0, s48
  v_lshrrev_b32 v1, s48, v16
  v_lshl_add_u32 v1, v22, 5, v1
  v_mul_u32_u24 v1, 1152, v1
  v_add_u32 v1, v1, v17
  s_mul_i32 s40, s61, s51
  s_lshl4_add_u32 s40, s50, s40
  s_lshl_b32 s40, s40, 3
  s_lshl_b32 s48, s61, 13
  s_add_u32 s48, s48, 135168
  s_add_u32 s49, s48, 4096
  s_lshl_b32 s50, s61, 8
  s_add_u32 s50, s50, 397312
  v_lshrrev_b32 v10, 5, v0
  v_bfe_u32 v22, v0, 3, 1
  v_xor_b32 v10, v10, v22
  v_lshlrev_b32 v10, 4, v10
  v_lshl_add_u32 v10, v17, 1, v10
  v_lshlrev_b32 v17, 4, v0
  s_mov_b64 s[28:29], s[26:27]
  s_mov_b32 s30, 1048576
L_lgate2:
  ds_read_b32 v22, v11 offset:44
  s_waitcnt lgkmcnt(0)
  v_cmp_gt_u32 vcc, s63, v22
  s_cbranch_vccnz L_lgate2
L_lgate2_ok:
  s_cmp_eq_u32 s3, 12
  s_cbranch_scc0 L_dgate_ok
  s_movk_i32 s63, 192
L_dgate:
  ds_read_b32 v22, v11 offset:40
  s_waitcnt lgkmcnt(0)
  v_cmp_gt_u32 vcc, s63, v22
  s_cbranch_vccnz L_dgate
L_dgate_ok:
  buffer_load_dword v63, v26, s[28:31], s45 offen sc1
  s_cmp_eq_u32 s43, 5
  s_cbranch_scc1 L_load8
  s_cmp_eq_u32 s72, 0
  s_cbranch_scc1 L_load16
  buffer_load_dwordx4 v[28:31], v10, s[28:31], s50 offen sc1
  buffer_load_dwordx4 v[32:35], v17, s[28:31], s48 offen offset:0 sc1
  buffer_load_dwordx4 v[36:39], v17, s[28:31], s48 offen offset:1024 sc1
  buffer_load_dwordx4 v[40:43], v17, s[28:31], s48 offen offset:2048 sc1
  buffer_load_dwordx4 v[44:47], v17, s[28:31], s48 offen offset:3072 sc1
  buffer_load_dwordx4 v[48:51], v17, s[28:31], s49 offen offset:0 sc1
  buffer_load_dwordx4 v[52:55], v17, s[28:31], s49 offen offset:1024 sc1
  buffer_load_dwordx4 v[56:59], v17, s[28:31], s49 offen offset:2048 sc1
  buffer_load_dwordx4 v[60:63], v17, s[28:31], s49 offen offset:3072 sc1
  s_branch L_load16
L_kwave:
L_touch5:
  s_cbranch_execz L_tret
  v_and_b32 v36, 15, v0
  v_lshlrev_b32 v36, 4, v36
  v_and_b32 v2, 8, v0
  v_lshl_add_u32 v36, v2, 5, v36
  v_xor_b32 v37, 256, v36
  v_lshlrev_b32 v2, 1, v2
  s_lshl_b32 s48, s62, 2
  v_add_u32 v3, s48, v2
  v_mov_b32 v4, 1
  s_lshl_b32 s48, s62, 8
  v_lshl_add_u32 v5, v0, 2, s48
  s_mov_b32 s64, 0xcccccccc
  s_mov_b32 s65, s64
  s_mov_b32 s66, 0xaaaaaaaa
  s_mov_b32 s67, s66
  s_mov_b32 s60, 0x3db504f3
  s_mov_b32 s61, 0x3fb8aa3b
L_qspin:
  ds_read_b32 v24, v11 offset:8
  s_waitcnt lgkmcnt(0)
  v_cmp_ne_u32 vcc, 1, v24
  s_cbranch_vccnz L_qspin
L_qspin_ok:
  ds_read_b32 v25, v11 offset:4
  ds_read_b128 v[16:19], v36 offset:1536
  ds_read_b128 v[20:23], v37 offset:1536
  s_waitcnt lgkmcnt(0)
  s_waitcnt vmcnt(12)
  v_dot2_f32_bf16 v44, v64, v20, 0
  v_dot2_f32_bf16 v28, v64, v16, 0
  v_dot2_f32_bf16 v45, v68, v20, 0
  v_dot2_f32_bf16 v29, v68, v16, 0
  v_dot2_f32_bf16 v46, v72, v20, 0
  v_dot2_f32_bf16 v30, v72, v16, 0
  v_dot2_f32_bf16 v47, v76, v20, 0
  v_dot2_f32_bf16 v31, v76, v16, 0
  v_dot2c_f32_bf16 v44, v65, v21
  v_dot2c_f32_bf16 v28, v65, v17
  v_dot2c_f32_bf16 v45, v69, v21
  v_dot2c_f32_bf16 v29, v69, v17
  v_dot2c_f32_bf16 v46, v73, v21
  v_dot2c_f32_bf16 v30, v73, v17
  v_dot2c_f32_bf16 v47, v77, v21
  v_dot2c_f32_bf16 v31, v77, v17
  v_dot2c_f32_bf16 v44, v66, v22
  v_dot2c_f32_bf16 v28, v66, v18
  v_dot2c_f32_bf16 v45, v70, v22
  v_dot2c_f32_bf16 v29, v70, v18
  v_dot2c_f32_bf16 v46, v74, v22
  v_dot2c_f32_bf16 v30, v74, v18
  v_dot2c_f32_bf16 v47, v78, v22
  v_dot2c_f32_bf16 v31, v78, v18
  v_dot2c_f32_bf16 v44, v67, v23
  v_dot2c_f32_bf16 v28, v67, v19
  v_dot2c_f32_bf16 v45, v71, v23
  v_dot2c_f32_bf16 v29, v71, v19
  v_dot2c_f32_bf16 v46, v75, v23
  v_dot2c_f32_bf16 v30, v75, v19
  v_dot2c_f32_bf16 v47, v79, v23
  v_dot2c_f32_bf16 v31, v79, v19
  v_add_f32_dpp v28, v44, v28 row_ror:8 row_mask:0xf bank_mask:0xf
  v_add_f32_dpp v29, v45, v29 row_ror:8 row_mask:0xf bank_mask:0xf
  v_add_f32_dpp v30, v46, v30 row_ror:8 row_mask:0xf bank_mask:0xf
  v_add_f32_dpp v31, v47, v31 row_ror:8 row_mask:0xf bank_mask:0xf
  v_add_f32_dpp v28, v28, v28 row_half_mirror row_mask:0xf bank_mask:0x5
  v_add_f32_dpp v29, v29, v29 row_half_mirror row_mask:0xf bank_mask:0x5
  v_add_f32_dpp v30, v30, v30 row_half_mirror row_mask:0xf bank_mask:0x5
  v_add_f32_dpp v31, v31, v31 row_half_mirror row_mask:0xf bank_mask:0x5
  s_waitcnt vmcnt(8)
  v_dot2_f32_bf16 v48, v80, v20, 0
  v_dot2_f32_bf16 v32, v80, v16, 0
  v_dot2_f32_bf16 v49, v84, v20, 0
  v_dot2_f32_bf16 v33, v84, v16, 0
  v_dot2_f32_bf16 v50, v88, v20, 0
  v_dot2_f32_bf16 v34, v88, v16, 0
  v_dot2_f32_bf16 v51, v92, v20, 0
  v_dot2_f32_bf16 v35, v92, v16, 0
  v_dot2c_f32_bf16 v48, v81, v21
  v_dot2c_f32_bf16 v32, v81, v17
  v_dot2c_f32_bf16 v49, v85, v21
  v_dot2c_f32_bf16 v33, v85, v17
  v_dot2c_f32_bf16 v50, v89, v21
  v_dot2c_f32_bf16 v34, v89, v17
  v_dot2c_f32_bf16 v51, v93, v21
  v_dot2c_f32_bf16 v35, v93, v17
  v_dot2c_f32_bf16 v48, v82, v22
  v_dot2c_f32_bf16 v32, v82, v18
  v_dot2c_f32_bf16 v49, v86, v22
  v_dot2c_f32_bf16 v33, v86, v18
  v_dot2c_f32_bf16 v50, v90, v22
  v_dot2c_f32_bf16 v34, v90, v18
  v_dot2c_f32_bf16 v51, v94, v22
  v_dot2c_f32_bf16 v35, v94, v18
  v_dot2c_f32_bf16 v48, v83, v23
  v_dot2c_f32_bf16 v32, v83, v19
  v_dot2c_f32_bf16 v49, v87, v23
  v_dot2c_f32_bf16 v33, v87, v19
  v_dot2c_f32_bf16 v50, v91, v23
  v_dot2c_f32_bf16 v34, v91, v19
  v_dot2c_f32_bf16 v51, v95, v23
  v_dot2c_f32_bf16 v35, v95, v19
  v_add_f32_dpp v32, v48, v32 row_ror:8 row_mask:0xf bank_mask:0xf
  v_add_f32_dpp v33, v49, v33 row_ror:8 row_mask:0xf bank_mask:0xf
  v_add_f32_dpp v34, v50, v34 row_ror:8 row_mask:0xf bank_mask:0xf
  v_add_f32_dpp v35, v51, v35 row_ror:8 row_mask:0xf bank_mask:0xf
  v_add_f32_dpp v32, v32, v32 row_half_mirror row_mask:0xf bank_mask:0x5
  v_add_f32_dpp v33, v33, v33 row_half_mirror row_mask:0xf bank_mask:0x5
  v_add_f32_dpp v34, v34, v34 row_half_mirror row_mask:0xf bank_mask:0x5
  v_add_f32_dpp v35, v35, v35 row_half_mirror row_mask:0xf bank_mask:0x5
  s_waitcnt vmcnt(4)
  v_dot2_f32_bf16 v52, v96, v20, 0
  v_dot2_f32_bf16 v36, v96, v16, 0
  v_dot2_f32_bf16 v53, v100, v20, 0
  v_dot2_f32_bf16 v37, v100, v16, 0
  v_dot2_f32_bf16 v54, v104, v20, 0
  v_dot2_f32_bf16 v38, v104, v16, 0
  v_dot2_f32_bf16 v55, v108, v20, 0
  v_dot2_f32_bf16 v39, v108, v16, 0
  v_dot2c_f32_bf16 v52, v97, v21
  v_dot2c_f32_bf16 v36, v97, v17
  v_dot2c_f32_bf16 v53, v101, v21
  v_dot2c_f32_bf16 v37, v101, v17
  v_dot2c_f32_bf16 v54, v105, v21
  v_dot2c_f32_bf16 v38, v105, v17
  v_dot2c_f32_bf16 v55, v109, v21
  v_dot2c_f32_bf16 v39, v109, v17
  v_dot2c_f32_bf16 v52, v98, v22
  v_dot2c_f32_bf16 v36, v98, v18
  v_dot2c_f32_bf16 v53, v102, v22
  v_dot2c_f32_bf16 v37, v102, v18
  v_dot2c_f32_bf16 v54, v106, v22
  v_dot2c_f32_bf16 v38, v106, v18
  v_dot2c_f32_bf16 v55, v110, v22
  v_dot2c_f32_bf16 v39, v110, v18
  v_dot2c_f32_bf16 v52, v99, v23
  v_dot2c_f32_bf16 v36, v99, v19
  v_dot2c_f32_bf16 v53, v103, v23
  v_dot2c_f32_bf16 v37, v103, v19
  v_dot2c_f32_bf16 v54, v107, v23
  v_dot2c_f32_bf16 v38, v107, v19
  v_dot2c_f32_bf16 v55, v111, v23
  v_dot2c_f32_bf16 v39, v111, v19
  v_add_f32_dpp v36, v52, v36 row_ror:8 row_mask:0xf bank_mask:0xf
  v_add_f32_dpp v37, v53, v37 row_ror:8 row_mask:0xf bank_mask:0xf
  v_add_f32_dpp v38, v54, v38 row_ror:8 row_mask:0xf bank_mask:0xf
  v_add_f32_dpp v39, v55, v39 row_ror:8 row_mask:0xf bank_mask:0xf
  v_add_f32_dpp v28, v36, v36 row_half_mirror row_mask:0xf bank_mask:0xa
  v_add_f32_dpp v29, v37, v37 row_half_mirror row_mask:0xf bank_mask:0xa
  v_add_f32_dpp v30, v38, v38 row_half_mirror row_mask:0xf bank_mask:0xa
  v_add_f32_dpp v31, v39, v39 row_half_mirror row_mask:0xf bank_mask:0xa
  s_waitcnt vmcnt(0)
  v_dot2_f32_bf16 v56, v112, v20, 0
  v_dot2_f32_bf16 v40, v112, v16, 0
  v_dot2_f32_bf16 v57, v116, v20, 0
  v_dot2_f32_bf16 v41, v116, v16, 0
  v_dot2_f32_bf16 v58, v120, v20, 0
  v_dot2_f32_bf16 v42, v120, v16, 0
  v_dot2_f32_bf16 v59, v124, v20, 0
  v_dot2_f32_bf16 v43, v124, v16, 0
  v_dot2c_f32_bf16 v56, v113, v21
  v_dot2c_f32_bf16 v40, v113, v17
  v_dot2c_f32_bf16 v57, v117, v21
  v_dot2c_f32_bf16 v41, v117, v17
  v_dot2c_f32_bf16 v58, v121, v21
  v_dot2c_f32_bf16 v42, v121, v17
  v_dot2c_f32_bf16 v59, v125, v21
  v_dot2c_f32_bf16 v43, v125, v17
  v_dot2c_f32_bf16 v56, v114, v22
  v_dot2c_f32_bf16 v40, v114, v18
  v_dot2c_f32_bf16 v57, v118, v22
  v_dot2c_f32_bf16 v41, v118, v18
  v_dot2c_f32_bf16 v58, v122, v22
  v_dot2c_f32_bf16 v42, v122, v18
  v_dot2c_f32_bf16 v59, v126, v22
  v_dot2c_f32_bf16 v43, v126, v18
  v_dot2c_f32_bf16 v56, v115, v23
  v_dot2c_f32_bf16 v40, v115, v19
  v_dot2c_f32_bf16 v57, v119, v23
  v_dot2c_f32_bf16 v41, v119, v19
  v_dot2c_f32_bf16 v58, v123, v23
  v_dot2c_f32_bf16 v42, v123, v19
  v_dot2c_f32_bf16 v59, v127, v23
  v_dot2c_f32_bf16 v43, v127, v19
  v_add_f32_dpp v40, v56, v40 row_ror:8 row_mask:0xf bank_mask:0xf
  v_add_f32_dpp v41, v57, v41 row_ror:8 row_mask:0xf bank_mask:0xf
  v_add_f32_dpp v42, v58, v42 row_ror:8 row_mask:0xf bank_mask:0xf
  v_add_f32_dpp v43, v59, v43 row_ror:8 row_mask:0xf bank_mask:0xf
  v_add_f32_dpp v32, v40, v40 row_half_mirror row_mask:0xf bank_mask:0xa
  v_add_f32_dpp v33, v41, v41 row_half_mirror row_mask:0xf bank_mask:0xa
  v_add_f32_dpp v34, v42, v42 row_half_mirror row_mask:0xf bank_mask:0xa
  v_add_f32_dpp v35, v43, v43 row_half_mirror row_mask:0xf bank_mask:0xa
  v_cndmask_b32 v44, v32, v28, s[64:65]
  v_cndmask_b32 v45, v33, v29, s[64:65]
  v_cndmask_b32 v46, v34, v30, s[64:65]
  v_cndmask_b32 v47, v35, v31, s[64:65]
L_touch6:
  s_cbranch_execz L_tret
  v_cndmask_b32 v28, v28, v32, s[64:65]
  v_cndmask_b32 v29, v29, v33, s[64:65]
  v_cndmask_b32 v30, v30, v34, s[64:65]
  v_cndmask_b32 v31, v31, v35, s[64:65]
  v_add_f32_dpp v28, v44, v28 quad_perm:[2,3,0,1] row_mask:0xf bank_mask:0xf
  v_add_f32_dpp v29, v45, v29 quad_perm:[2,3,0,1] row_mask:0xf bank_mask:0xf
  v_add_f32_dpp v30, v46, v30 quad_perm:[2,3,0,1] row_mask:0xf bank_mask:0xf
  v_add_f32_dpp v31, v47, v31 quad_perm:[2,3,0,1] row_mask:0xf bank_mask:0xf
  v_cndmask_b32 v44, v30, v28, s[66:67]
  v_cndmask_b32 v45, v31, v29, s[66:67]
  v_cndmask_b32 v28, v28, v30, s[66:67]
  v_cndmask_b32 v29, v29, v31, s[66:67]
  v_add_f32_dpp v28, v44, v28 quad_perm:[1,0,3,2] row_mask:0xf bank_mask:0xf
  v_add_f32_dpp v29, v45, v29 quad_perm:[1,0,3,2] row_mask:0xf bank_mask:0xf
  v_cvt_pk_bf16_f32 v44, v28, v29
  v_lshlrev_b32 v28, 16, v44
  v_and_b32 v29, s53, v44
  v_mul_f32 v28, s60, v28
  v_mul_f32 v29, s60, v29
  v_cvt_pk_bf16_f32 v44, v28, v29
  v_lshlrev_b32 v28, 16, v44
  v_and_b32 v29, s53, v44
  v_max_f32 v60, v28, v29
  s_nop 1
  v_max_f32_dpp v60, v60, v60 row_half_mirror row_mask:0xf bank_mask:0xf
  s_nop 1
  v_max_f32_dpp v60, v60, v60 quad_perm:[1,0,3,2] row_mask:0xf bank_mask:0xf
  s_nop 1
  v_max_f32_dpp v60, v60, v60 quad_perm:[2,3,0,1] row_mask:0xf bank_mask:0xf
  v_mov_b32 v61, v60
  s_nop 1
  v_permlane16_swap_b32 v60, v61
  v_max_f32 v60, v60, v61
  v_mov_b32 v61, v60
  s_nop 1
  v_permlane32_swap_b32 v60, v61
  v_max_f32 v60, v60, v61
  v_sub_f32 v28, v28, v60
  v_sub_f32 v29, v29, v60
  v_mul_f32 v28, s61, v28
  v_mul_f32 v29, s61, v29
  v_exp_f32 v28, v28
  v_exp_f32 v29, v29
  ds_write_b32 v3, v60 offset:64
  v_cvt_pk_bf16_f32 v44, v28, v29
  v_add_f32 v61, v28, v29
  ds_write_b32 v5, v44 offset:2048
  s_nop 1
  v_add_f32_dpp v61, v61, v61 row_half_mirror row_mask:0xf bank_mask:0xf
  s_nop 1
  v_add_f32_dpp v61, v61, v61 quad_perm:[1,0,3,2] row_mask:0xf bank_mask:0xf
  s_nop 1
  v_add_f32_dpp v61, v61, v61 quad_perm:[2,3,0,1] row_mask:0xf bank_mask:0xf
  v_mov_b32 v62, v61
  s_nop 1
  v_permlane16_swap_b32 v61, v62
  v_add_f32 v61, v61, v62
  v_mov_b32 v62, v61
  s_nop 1
  v_permlane32_swap_b32 v61, v62
  v_add_f32 v61, v61, v62
  s_mov_b64 exec, 0x101
  ds_write_b32 v3, v61 offset:96
  s_mov_b64 exec, 1
  ds_add_rtn_u32 v6, v11, v4 offset:16
  s_waitcnt lgkmcnt(0)
  v_cmp_eq_u32 vcc, 3, v6
  s_cbranch_vccz L_exit
  s_mov_b64 exec, 0x101
  ds_read_b128 v[16:19], v2 offset:64
  ds_read_b128 v[20:23], v2 offset:96
  v_mov_b32 v62, v25
  v_mov_b32 v63, v25
  v_lshlrev_b32 v2, 4, v2
  s_lshl_b32 s48, s46, 9
  s_lshl_b32 s49, s47, 4
  s_add_u32 s48, s48, s49
  s_add_u32 s48, s48, 397312
  s_waitcnt lgkmcnt(0)
  v_max3_f32 v60, v16, v17, v18
  v_max_f32 v60, v60, v19
  v_sub_f32 v16, v16, v60
  v_sub_f32 v17, v17, v60
  v_sub_f32 v18, v18, v60
  v_sub_f32 v19, v19, v60
  v_mul_f32 v16, s61, v16
  v_mul_f32 v17, s61, v17
  v_mul_f32 v18, s61, v18
  v_mul_f32 v19, s61, v19
  v_exp_f32 v16, v16
  v_exp_f32 v17, v17
  v_exp_f32 v18, v18
  v_exp_f32 v19, v19
  v_mul_f32 v61, v16, v20
  v_fmac_f32 v61, v17, v21
  v_fmac_f32 v61, v18, v22
  v_fmac_f32 v61, v19, v23
  buffer_store_dwordx4 v[60:63], v2, s[28:31], s48 offen sc1
  s_branch L_exit
L_vwave:
  s_lshl_b32 s48, s62, 8
  v_lshl_add_u32 v41, v16, 5, s48
  v_lshrrev_b32 v40, 5, v0
  v_lshlrev_b32 v42, 4, v40
  s_lshl_b32 s48, s62, 2
  v_add_u32 v43, s48, v42
  v_lshlrev_b32 v36, 4, v0
  s_lshl_b32 s48, s62, 10
  v_add_u32 v37, s48, v36
  v_mov_b32 v38, 1
  v_and_b32 v39, 15, v0
  v_and_b32 v44, 16, v0
  v_lshl_add_u32 v39, v39, 5, v44
  v_lshl_add_u32 v39, v40, 13, v39
  s_lshl_b32 s45, s46, 14
  s_lshl_b32 s49, s47, 9
  s_add_u32 s45, s45, s49
  s_add_u32 s45, s45, 135168
L_pspin:
  ds_read_b32 v40, v11 offset:16
  s_waitcnt lgkmcnt(0)
  v_cmp_ne_u32 vcc, 4, v40
  s_cbranch_vccnz L_pspin
L_pspin_ok:
  ds_read_b128 v[28:31], v41 offset:2048
  ds_read_b128 v[32:35], v41 offset:2064
  ds_read_b128 v[44:47], v42 offset:64
  ds_read_b32 v43, v43 offset:64
  ds_read_b32 v24, v11 offset:4
  s_waitcnt lgkmcnt(0)
  v_max3_f32 v44, v44, v45, v46
  v_max_f32 v44, v44, v47
  v_sub_f32 v43, v43, v44
  v_mul_f32 v43, 0x3fb8aa3b, v43
  v_exp_f32 v43, v43
  v_and_b32 v24, 0xff, v24
  s_branch L_gemv16
L_vpost:
  s_nop 2
  v_mul_f32 v12, v43, v12
  v_mul_f32 v13, v43, v13
  v_mul_f32 v14, v43, v14
  v_mul_f32 v15, v43, v15
  ds_write_b128 v37, v[12:15] offset:4096
  s_mov_b64 exec, 1
  ds_add_rtn_u32 v40, v11, v38 offset:20
  s_waitcnt lgkmcnt(0)
  v_cmp_eq_u32 vcc, 3, v40
  s_cbranch_vccz L_exit
  s_mov_b64 exec, -1
  ds_read_b128 v[64:67], v36 offset:4096
  ds_read_b128 v[68:71], v36 offset:5120
  ds_read_b128 v[72:75], v36 offset:6144
  ds_read_b128 v[76:79], v36 offset:7168
  s_waitcnt lgkmcnt(2)
  v_add_f32 v64, v64, v68
  v_add_f32 v65, v65, v69
L_touch7:
  s_cbranch_execz L_tret
  v_add_f32 v66, v66, v70
  v_add_f32 v67, v67, v71
  s_waitcnt lgkmcnt(0)
  v_add_f32 v72, v72, v76
  v_add_f32 v73, v73, v77
  v_add_f32 v74, v74, v78
  v_add_f32 v75, v75, v79
  v_add_f32 v64, v64, v72
  v_add_f32 v65, v65, v73
  v_add_f32 v66, v66, v74
  v_add_f32 v67, v67, v75
  v_and_or_b32 v64, v64, s55, v24
  buffer_store_dwordx4 v[64:67], v39, s[28:31], s45 offen sc1
  s_branch L_exit
L_st2:
L_farw:
  ds_read_b32 v19, v11 offset:12
  s_waitcnt lgkmcnt(0)
  v_cmp_eq_u32 vcc, 0, v19
  s_cbranch_vccnz L_farw
L_farw_ok:
  v_readfirstlane_b32 s76, v19
  s_mov_b32 s60, 0x3fb8aa3b
  s_cmp_eq_u32 s43, 5
  s_cbranch_scc1 L_w2h
  v_lshlrev_b32 v1, 4, v0
  s_cmp_eq_u32 s72, 1
  s_waitcnt vmcnt(16)
  s_cbranch_scc1 L_ochk
L_opoll:
  s_waitcnt vmcnt(4)
  s_mov_b32 s72, 0
  buffer_load_dwordx4 v[28:31], v10, s[28:31], s50 offen sc1
  buffer_load_dwordx4 v[32:35], v1, s[28:31], s48 offen offset:0 sc1
  buffer_load_dwordx4 v[36:39], v1, s[28:31], s48 offen offset:1024 sc1
  buffer_load_dwordx4 v[40:43], v1, s[28:31], s48 offen offset:2048 sc1
  buffer_load_dwordx4 v[44:47], v1, s[28:31], s48 offen offset:3072 sc1
  buffer_load_dwordx4 v[48:51], v1, s[28:31], s49 offen offset:0 sc1
  buffer_load_dwordx4 v[52:55], v1, s[28:31], s49 offen offset:1024 sc1
  buffer_load_dwordx4 v[56:59], v1, s[28:31], s49 offen offset:2048 sc1
  buffer_load_dwordx4 v[60:63], v1, s[28:31], s49 offen offset:3072 sc1
  s_sub_u32 s52, s52, 1
  s_cbranch_scc1 L_fin
  s_waitcnt vmcnt(8)
L_ochk:
  ds_write_b32 v11, v18 offset:48
  v_max_f32_dpp v17, v28, v28 row_ror:8 row_mask:0xf bank_mask:0xf
  s_nop 1
  v_max_f32_dpp v17, v17, v17 row_ror:4 row_mask:0xf bank_mask:0xf
  s_nop 1
  v_max_f32_dpp v17, v17, v17 row_ror:2 row_mask:0xf bank_mask:0xf
  s_nop 1
  v_max_f32_dpp v17, v17, v17 row_ror:1 row_mask:0xf bank_mask:0xf
  v_sub_f32 v17, v28, v17
  v_mul_f32 v17, s60, v17
  v_exp_f32 v17, v17
  s_cmp_eq_u32 s72, 1
  s_cbranch_scc1 L_onw
  s_waitcnt vmcnt(0)
L_onw:
  v_mul_f32 v29, v17, v29
  v_xor_b32 v32, v24, v32
  v_xor_b32 v36, v24, v36
  v_xor_b32 v40, v24, v40
  v_xor_b32 v44, v24, v44
  v_xor_b32 v48, v24, v48
  v_xor_b32 v52, v24, v52
  v_xor_b32 v56, v24, v56
  v_xor_b32 v60, v24, v60
  v_or3_b32 v19, v32, v36, v40
  v_or3_b32 v19, v19, v44, v48
  v_or3_b32 v19, v19, v52, v56
  v_bitop3_b32 v19, v19, v60, s55 bitop3:0x54
  v_bitop3_b32 v19, v30, s44, v19 bitop3:0xbe
  v_cmp_ne_u32 vcc, 0, v19
  s_cbranch_vccnz L_opoll
  v_add_f32_dpp v29, v29, v29 row_ror:8 row_mask:0xf bank_mask:0xf
  v_mul_f32_dpp v20, v17, v32 row_newbcast:0 row_mask:0xf bank_mask:0xf
  v_mul_f32_dpp v21, v17, v33 row_newbcast:0 row_mask:0xf bank_mask:0xf
  v_mul_f32_dpp v22, v17, v34 row_newbcast:0 row_mask:0xf bank_mask:0xf
  v_mul_f32_dpp v23, v17, v35 row_newbcast:0 row_mask:0xf bank_mask:0xf
  v_add_f32_dpp v29, v29, v29 row_ror:4 row_mask:0xf bank_mask:0xf
  v_fmac_f32_dpp v20, v17, v36 row_newbcast:1 row_mask:0xf bank_mask:0xf
  v_fmac_f32_dpp v21, v17, v37 row_newbcast:1 row_mask:0xf bank_mask:0xf
  v_fmac_f32_dpp v22, v17, v38 row_newbcast:1 row_mask:0xf bank_mask:0xf
  v_fmac_f32_dpp v23, v17, v39 row_newbcast:1 row_mask:0xf bank_mask:0xf
  v_add_f32_dpp v29, v29, v29 row_ror:2 row_mask:0xf bank_mask:0xf
  v_fmac_f32_dpp v20, v17, v40 row_newbcast:2 row_mask:0xf bank_mask:0xf
  v_fmac_f32_dpp v21, v17, v41 row_newbcast:2 row_mask:0xf bank_mask:0xf
  v_fmac_f32_dpp v22, v17, v42 row_newbcast:2 row_mask:0xf bank_mask:0xf
  v_fmac_f32_dpp v23, v17, v43 row_newbcast:2 row_mask:0xf bank_mask:0xf
  v_add_f32_dpp v29, v29, v29 row_ror:1 row_mask:0xf bank_mask:0xf
  v_fmac_f32_dpp v20, v17, v44 row_newbcast:3 row_mask:0xf bank_mask:0xf
  v_fmac_f32_dpp v21, v17, v45 row_newbcast:3 row_mask:0xf bank_mask:0xf
  v_fmac_f32_dpp v22, v17, v46 row_newbcast:3 row_mask:0xf bank_mask:0xf
  v_fmac_f32_dpp v23, v17, v47 row_newbcast:3 row_mask:0xf bank_mask:0xf
  v_rcp_f32 v29, v29
  v_fmac_f32_dpp v20, v17, v48 row_newbcast:4 row_mask:0xf bank_mask:0xf
  v_fmac_f32_dpp v21, v17, v49 row_newbcast:4 row_mask:0xf bank_mask:0xf
  v_fmac_f32_dpp v22, v17, v50 row_newbcast:4 row_mask:0xf bank_mask:0xf
  v_fmac_f32_dpp v23, v17, v51 row_newbcast:4 row_mask:0xf bank_mask:0xf
  v_fmac_f32_dpp v20, v17, v52 row_newbcast:5 row_mask:0xf bank_mask:0xf
  v_fmac_f32_dpp v21, v17, v53 row_newbcast:5 row_mask:0xf bank_mask:0xf
  v_fmac_f32_dpp v22, v17, v54 row_newbcast:5 row_mask:0xf bank_mask:0xf
  v_fmac_f32_dpp v23, v17, v55 row_newbcast:5 row_mask:0xf bank_mask:0xf
  v_fmac_f32_dpp v20, v17, v56 row_newbcast:6 row_mask:0xf bank_mask:0xf
  v_fmac_f32_dpp v21, v17, v57 row_newbcast:6 row_mask:0xf bank_mask:0xf
  v_fmac_f32_dpp v22, v17, v58 row_newbcast:6 row_mask:0xf bank_mask:0xf
  v_fmac_f32_dpp v23, v17, v59 row_newbcast:6 row_mask:0xf bank_mask:0xf
  v_fmac_f32_dpp v20, v17, v60 row_newbcast:7 row_mask:0xf bank_mask:0xf
  v_fmac_f32_dpp v21, v17, v61 row_newbcast:7 row_mask:0xf bank_mask:0xf
  v_fmac_f32_dpp v22, v17, v62 row_newbcast:7 row_mask:0xf bank_mask:0xf
  v_fmac_f32_dpp v23, v17, v63 row_newbcast:7 row_mask:0xf bank_mask:0xf
  s_nop 0
  v_permlane32_swap_b32 v20, v21
  v_permlane32_swap_b32 v22, v23
  v_add_f32 v20, v20, v21
  v_add_f32 v22, v22, v23
  v_mul_f32 v20, v20, v29
  v_mul_f32 v22, v22, v29
  v_cvt_pk_bf16_f32 v27, v20, v22
  s_nop 1
  v_mov_b32_dpp v28, v27 row_newbcast:0 row_mask:0xf bank_mask:0x3
  v_mov_b32_dpp v28, v27 row_newbcast:8 row_mask:0xf bank_mask:0xc
  v_mov_b32_dpp v29, v27 row_newbcast:1 row_mask:0xf bank_mask:0x3
  v_mov_b32_dpp v29, v27 row_newbcast:9 row_mask:0xf bank_mask:0xc
  v_mov_b32_dpp v30, v27 row_newbcast:2 row_mask:0xf bank_mask:0x3
  v_mov_b32_dpp v30, v27 row_newbcast:10 row_mask:0xf bank_mask:0xc
  v_mov_b32_dpp v31, v27 row_newbcast:3 row_mask:0xf bank_mask:0x3
  v_mov_b32_dpp v31, v27 row_newbcast:11 row_mask:0xf bank_mask:0xc
  v_mov_b32_dpp v32, v27 row_newbcast:4 row_mask:0xf bank_mask:0x3
  v_mov_b32_dpp v32, v27 row_newbcast:12 row_mask:0xf bank_mask:0xc
  v_mov_b32_dpp v33, v27 row_newbcast:5 row_mask:0xf bank_mask:0x3
  v_mov_b32_dpp v33, v27 row_newbcast:13 row_mask:0xf bank_mask:0xc
  v_mov_b32_dpp v34, v27 row_newbcast:6 row_mask:0xf bank_mask:0x3
  v_mov_b32_dpp v34, v27 row_newbcast:14 row_mask:0xf bank_mask:0xc
  v_mov_b32_dpp v35, v27 row_newbcast:7 row_mask:0xf bank_mask:0x3
  v_mov_b32_dpp v35, v27 row_newbcast:15 row_mask:0xf bank_mask:0xc
  s_branch L_gemv16
L_w2h:
  s_lshl_b32 s48, s61, 8
  s_add_u32 s48, s48, 737280
  s_add_u32 s49, s48, 73728
  v_and_b32 v27, 15, v0
  v_lshrrev_b32 v21, 4, v0
  v_mul_u32_u24 v1, 18432, v21
  v_lshl_add_u32 v1, v27, 4, v1
L_lw:
  ds_read_b32 v19, v11 offset:48
  s_waitcnt lgkmcnt(0)
  v_cmp_ne_u32 vcc, 1, v19
  s_cbranch_vccnz L_lw
L_lw_ok:
L_gpoll:
  buffer_load_dwordx4 v[40:43], v1, s[28:31], s48 offen sc1
  buffer_load_dwordx4 v[44:47], v1, s[28:31], s49 offen sc1
  s_sub_u32 s52, s52, 1
  s_cbranch_scc1 L_fin
  s_waitcnt vmcnt(0)
  v_xor_b32 v40, v24, v40
  v_xor_b32 v44, v24, v44
  v_bitop3_b32 v19, v40, v44, s55 bitop3:0x54
  v_cmp_ne_u32 vcc, 0, v19
  s_cbranch_vccnz L_gpoll
  v_permlane32_swap_b32 v40, v44
  v_permlane32_swap_b32 v41, v45
  v_permlane32_swap_b32 v42, v46
  v_permlane32_swap_b32 v43, v47
  v_pk_add_f32 v[40:41], v[40:41], v[44:45]
  v_pk_add_f32 v[42:43], v[42:43], v[46:47]
  s_nop 0
  v_permlane16_swap_b32 v40, v41
  v_permlane16_swap_b32 v42, v43
  v_add_f32 v40, v40, v41
  v_add_f32 v42, v42, v43
  s_nop 1
  v_permlane32_swap_b32 v40, v42
  v_cvt_pk_bf16_f32 v48, v40, v42
  v_lshlrev_b32 v49, 16, v48
  v_mul_f32 v50, s60, v49
  v_exp_f32 v50, -v50
  v_and_b32 v48, s53, v48
  v_add_f32 v50, 1.0, v50
  v_rcp_f32 v50, v50
  s_nop 0
  v_mul_f32 v49, v49, v50
  v_cvt_pk_bf16_f32 v49, v49, v49
  v_and_b32 v49, s53, v49
  v_mul_f32 v49, v49, v48
  s_nop 1
  v_mov_b32_dpp v48, v49 quad_perm:[1,0,3,2] row_mask:0xf bank_mask:0xf
L_touch8:
  s_cbranch_execz L_tret
  v_cvt_pk_bf16_f32 v27, v49, v48
  s_nop 1
  v_mov_b32_dpp v32, v27 row_newbcast:0 row_mask:0xf bank_mask:0x3
  v_mov_b32_dpp v32, v27 row_newbcast:8 row_mask:0xf bank_mask:0xc
  v_mov_b32_dpp v33, v27 row_newbcast:2 row_mask:0xf bank_mask:0x3
  v_mov_b32_dpp v33, v27 row_newbcast:10 row_mask:0xf bank_mask:0xc
  v_mov_b32_dpp v34, v27 row_newbcast:4 row_mask:0xf bank_mask:0x3
  v_mov_b32_dpp v34, v27 row_newbcast:12 row_mask:0xf bank_mask:0xc
  v_mov_b32_dpp v35, v27 row_newbcast:6 row_mask:0xf bank_mask:0x3
  v_mov_b32_dpp v35, v27 row_newbcast:14 row_mask:0xf bank_mask:0xc
  s_branch L_gemv8
L_exit:
L_end:
  s_endpgm

.section .rodata,"a"
.p2align 6
.amdhsa_kernel recurrent_scan__sliding_block_cached__glu_gated_swiglu__decode_kernel
  .amdhsa_next_free_vgpr 128
  .amdhsa_next_free_sgpr 100
  .amdhsa_accum_offset 128
  .amdhsa_group_segment_fixed_size 0
  .amdhsa_kernarg_size 96
  .amdhsa_user_sgpr_count 2
  .amdhsa_user_sgpr_kernarg_segment_ptr 1
  .amdhsa_system_sgpr_workgroup_id_x 1
.end_amdhsa_kernel
```
